```python
import torch

def _softmax(x, axis=-1):
    return torch.softmax(x, dim=axis)
def _gelu(x):
    return torch.nn.functional.gelu(x, approximate="tanh")
def _silu(x):
    return torch.nn.functional.silu(x)
def _sigmoid(x):
    return torch.sigmoid(x)
def _layernorm(x, axis=-1, eps=1e-5):
    m = x.mean(dim=axis, keepdim=True)
    v = x.var(dim=axis, keepdim=True, unbiased=False)
    return (x - m) / torch.sqrt(v + eps)
def _scatter_add(tgt, idx, src, axis=0):
    return tgt.clone().index_add_(axis, idx, src)
def _segment_sum(src, seg, n):
    out = torch.zeros((n,) + src.shape[1:], dtype=src.dtype)
    return out.index_add_(0, seg, src)
def _pad(x, pw):
    flat = tuple(v for pair in reversed(pw) for v in pair)
    return torch.nn.functional.pad(x, flat)

kernel_name = 'standalone__sliding_block_cached__decode'

def setup_inputs():

    _w = (lambda a: (lambda t: t.to(torch.bfloat16) if t.is_floating_point() else t)(torch.as_tensor(a)))
    B, Sq, D = 1, 1, 448
    Hq, Hkv, Sk, Dh = 16, 8, 65536, 256
    assert Hq % Hkv == 0, (Hq, Hkv)
    return {
        "x": _w((lambda *s: torch.randn(*s, dtype=torch.bfloat16) * 0.8)(B, Sq, D)),
        "k_cache": _w((lambda *s: torch.randn(*s, dtype=torch.bfloat16) * 0.8)(B, Hkv, Sk, Dh)),
        "v_cache": _w((lambda *s: torch.randn(*s, dtype=torch.bfloat16) * 0.05)(B, Hkv, Sk, Dh)),
        "wq": _w((lambda *s: torch.randn(*s, dtype=torch.bfloat16) * 0.8)(D, Hq * Dh) * (D ** -0.5)),
        "wo": _w((lambda *s: torch.randn(*s, dtype=torch.bfloat16) * 0.05)(Hq * Dh, D) * ((Hq * Dh) ** -0.5)),
    }

def reference(x, k_cache, v_cache, wq, wo):
    B, Sq, D = x.shape
    Hq, Dh = 16, 256
    Hkv, Sk = k_cache.shape[1], k_cache.shape[2]
    W = min(4096, max(256, Sk // 4))
    rep = Hq // Hkv
    q = (lambda x, *d: x.permute(*d))((x @ wq).reshape(B, Sq, Hq, Dh), 0, 2, 1, 3)
    k = (lambda x, n, axis: torch.repeat_interleave(x, n, dim=axis))(k_cache[:, :, Sk - W:, :], rep, axis=1)
    v = (lambda x, n, axis: torch.repeat_interleave(x, n, dim=axis))(v_cache[:, :, Sk - W:, :], rep, axis=1)
    scores = torch.einsum("bhqd,bhkd->bhqk", q, k) * (Dh ** -0.5)
    p = _softmax(scores, axis=-1)
    o = torch.einsum("bhqk,bhkd->bhqd", p, v)
    return (lambda x, *d: x.permute(*d))(o, 0, 2, 1, 3).reshape(B, Sq, Hq * Dh) @ wo
```

```asm
; @launch grid=(256,1,1) block=(512,1,1) lds=149760
.amdgcn_target "amdgcn-amd-amdhsa--gfx950"
.text
.globl standalone__sliding_block_cached__decode_kernel
.p2align 8
.type standalone__sliding_block_cached__decode_kernel,@function
standalone__sliding_block_cached__decode_kernel:
    s_cmp_ge_u32 s2, 256
    s_cbranch_scc1 L_end
    s_load_dwordx16 s[4:19], s[0:1], 0
    v_lshrrev_b32 v1, 6, v0
    s_and_b32 s20, s2, 7
    s_lshr_b32 s21, s2, 3
    v_readfirstlane_b32 s22, v1
    v_and_b32 v0, 63, v0
    s_lshr_b32 s75, s21, 2
    s_and_b32 s76, s21, 3
    s_lshl_b32 s52, s20, 25
    s_add_u32 s68, s52, 31457280
    s_cmp_ge_u32 s22, 4
    s_cbranch_scc1 L_loader
    s_setprio 3
    s_getreg_b32 s64, hwreg(HW_REG_XCC_ID, 0, 4)
    v_and_b32 v2, 15, v0
    v_lshrrev_b32 v3, 4, v0
    s_lshr_b32 s52, s21, 3
    s_mul_i32 s52, s52, 224
    v_lshl_add_u32 v1, v3, 4, s52
    v_lshl_add_u32 v22, v3, 3, s52
    v_mov_b32 v180, 0
    v_lshrrev_b32 v23, 3, v0
    v_lshlrev_b32 v23, 12, v23
    v_and_b32 v26, 7, v0
    v_lshl_add_u32 v184, v26, 4, v23
    v_lshlrev_b32 v185, 2, v0
    v_lshlrev_b32 v7, 4, v0
    s_lshl_b32 s53, s20, 17
    s_lshl_b32 s54, s22, 15
    s_add_u32 s53, s53, s54
    s_lshl_b32 s54, s21, 7
    s_add_u32 s53, s53, s54
    s_add_u32 s56, s53, 262144
    s_lshl_b32 s53, s20, 13
    s_lshr_b32 s54, s21, 3
    s_lshl_b32 s54, s54, 11
    s_add_u32 s53, s53, s54
    s_and_b32 s54, s21, 7
    s_lshl_b32 s54, s54, 8
    s_add_u32 s53, s53, s54
    s_lshl_b32 s54, s22, 6
    s_add_u32 s57, s53, s54
    s_cmp_lg_u32 s22, 0
    s_cbranch_scc1 L_noinit
    v_lshlrev_b32 v27, 2, v0
    v_add_u32 v27, 149504, v27
    s_mov_b64 exec, 0xffffffff
    ds_write_b32 v27, v180
    s_mov_b64 exec, -1
L_noinit:
    s_waitcnt lgkmcnt(0)
    s_mov_b32 s36, s4
    s_and_b32 s37, s5, 0xffff
    s_mov_b32 s38, 896
    s_mov_b32 s39, 0x20000
    s_load_dword s23, s[18:19], 0
    buffer_load_dwordx4 v[8:11], v1, s[36:39], 0 offen
    buffer_load_dwordx4 v[12:15], v1, s[36:39], 0 offen offset:64
    buffer_load_dwordx4 v[16:19], v1, s[36:39], 0 offen offset:128
    buffer_load_dwordx2 v[20:21], v22, s[36:39], 0 offen offset:192
    s_barrier
    s_mov_b32 s44, s18
    s_and_b32 s45, s19, 0xffff
    s_mov_b32 s46, 8388608
    s_mov_b32 s47, 0x20000
    s_mov_b32 s48, s14
    s_and_b32 s49, s15, 0xffff
    s_mov_b32 s50, 896
    s_mov_b32 s51, 0x20000
    s_add_u32 s52, s57, 65536
    s_mov_b64 exec, 0xf
    buffer_load_dwordx4 v[176:179], v7, s[44:47], s52 offen
    s_mov_b64 exec, -1
    s_mov_b32 s58, 0xffff0000
    s_mov_b32 s59, 0xffff0000
    s_mov_b32 s60, 0
    s_mov_b32 s61, -1
    s_mov_b32 s62, 0xaaaaaaaa
    s_mov_b32 s63, 0xaaaaaaaa
    v_and_b32 v1, 3, v0
    v_lshlrev_b32 v1, 2, v1
    v_add_u32 v4, 149504, v1
    v_add_u32 v5, 149520, v1
    v_add_u32 v6, 149536, v1
    v_lshrrev_b32 v1, 2, v2
    v_and_b32 v27, 3, v2
    v_lshl_add_u32 v22, v3, 3, v1
    v_lshlrev_b32 v22, 7, v22
    v_lshl_add_u32 v22, v27, 3, v22
    v_lshrrev_b32 v23, 1, v1
    v_and_b32 v26, 1, v3
    v_lshl_add_u32 v26, v26, 1, v23
    v_xor_b32 v26, s22, v26
    v_lshl_add_u32 v22, v26, 5, v22
    v_add_u32 v24, 131072, v22
    v_lshl_add_u32 v22, v3, 2, v1
    v_lshlrev_b32 v22, 7, v22
    v_lshl_add_u32 v22, v27, 3, v22
    v_lshrrev_b32 v26, 1, v3
    v_lshl_add_u32 v26, v26, 1, v23
    v_xor_b32 v26, s22, v26
    v_lshl_add_u32 v22, v26, 5, v22
    v_add_u32 v25, 143360, v22
    s_lshl_b32 s52, s20, 13
    s_lshl_b32 s53, s22, 9
    s_add_u32 s52, s52, s53
    s_add_u32 s68, s52, 65536
    s_add_u32 s69, s68, 4096
    v_lshrrev_b32 v1, 5, v0
    v_and_b32 v22, 31, v0
    v_lshlrev_b32 v22, 4, v22
    v_lshl_add_u32 v186, v1, 11, v22
    v_and_b32 v22, 3, v0
    v_lshrrev_b32 v187, v22, s64
    v_and_b32 v187, 1, v187
    v_lshlrev_b32 v187, 8, v187
    s_mov_b32 s24, 0x05030201
    s_mov_b32 s25, 0x06050302
    s_mov_b32 s26, 0x07060503
    s_mov_b32 s27, 0xfffffe00
    s_lshl_b32 s52, s20, 17
    s_lshl_b32 s53, s75, 14
    s_add_u32 s52, s52, s53
    s_lshl_b32 s53, s22, 12
    s_add_u32 s52, s52, s53
    s_add_u32 s77, s52, 262144
L_wq_1:
    ds_read_b32 v1, v4 offset:0
    s_waitcnt lgkmcnt(0)
    v_cmp_le_u32 vcc, 4, v1
    s_cmp_eq_u64 vcc, -1
    s_cbranch_scc1 L_wq_1_ok
    s_sleep 1
    s_branch L_wq_1
L_wq_1_ok:
    ds_read_b64_tr_b16 v[28:29], v24 offset:0
    ds_read_b64_tr_b16 v[30:31], v24 offset:512
    ds_read_b64_tr_b16 v[32:33], v24 offset:4096
    ds_read_b64_tr_b16 v[34:35], v24 offset:4608
    ds_read_b64_tr_b16 v[36:37], v24 offset:8192
    ds_read_b64_tr_b16 v[38:39], v24 offset:8704
    ds_read_b64_tr_b16 v[40:41], v25
    s_waitcnt vmcnt(1) lgkmcnt(0)
    v_mfma_f32_16x16x16_bf16 v[48:51], v[20:21], v[40:41], 0
    v_mfma_f32_16x16x32_bf16 v[44:47], v[8:11], v[28:31], 0
    v_mfma_f32_16x16x32_bf16 v[44:47], v[12:15], v[32:35], v[44:47]
    v_mfma_f32_16x16x32_bf16 v[44:47], v[16:19], v[36:39], v[44:47]
    s_add_u32 s23, s23, 0x9e3779b1
    s_or_b32 s23, s23, 1
    s_add_u32 s52, s57, 65536
    s_add_u32 s53, s57, 1572864
    s_nop 4
    v_add_f32 v56, v44, v48
    v_add_u32 v56, 0x100, v56
    v_and_or_b32 v56, v56, s27, v187
    v_mov_b32 v51, s23
    s_nop 0
    v_mov_b32_dpp v52, v56 quad_perm:[0,0,0,0] row_mask:0xf bank_mask:0xf
    v_mov_b32_dpp v53, v56 quad_perm:[1,1,1,1] row_mask:0xf bank_mask:0xf
    v_mov_b32_dpp v54, v56 quad_perm:[2,2,2,2] row_mask:0xf bank_mask:0xf
    v_mov_b32_dpp v55, v56 quad_perm:[3,3,3,3] row_mask:0xf bank_mask:0xf
    v_perm_b32 v48, v53, v52, s24
    v_perm_b32 v49, v54, v53, s25
    v_perm_b32 v50, v55, v54, s26
    s_mov_b64 exec, 0x1111
    buffer_store_dwordx4 v[48:51], v185, s[44:47], s52 offen
    buffer_store_dwordx4 v[48:51], v185, s[44:47], s53 offen sc1
    s_mov_b64 exec, -1
    s_mov_b32 s74, 200000
    s_mov_b32 s24, 0
    s_mov_b32 s73, 0
    s_lshl_b32 s72, s22, 2
    s_add_u32 s72, s72, 8
    buffer_load_dwordx4 v[52:55], v186, s[44:47], s68 offen sc1
    buffer_load_dwordx4 v[56:59], v186, s[44:47], s69 offen sc1
    v_and_b32 v1, 1, v2
    v_lshlrev_b32 v22, 9, v1
    v_lshl_add_u32 v22, v3, 4, v22
    v_add_u32 v26, 147456, v22
    v_lshlrev_b32 v22, 8, v1
    v_lshl_add_u32 v22, v3, 4, v22
    v_add_u32 v27, 148480, v22
    v_xor_b32 v1, v3, v2
    v_lshlrev_b32 v1, 4, v1
    v_lshl_add_u32 v1, v2, 9, v1
    s_lshl_b32 s52, s22, 14
    v_add_u32 v28, s52, v1
    v_xor_b32 v29, 64, v28
    v_xor_b32 v30, 128, v28
    v_xor_b32 v31, 192, v28
    v_lshrrev_b32 v1, 2, v2
    v_and_b32 v22, 3, v2
    v_lshl_add_u32 v23, v3, 3, v1
    v_lshlrev_b32 v23, 9, v23
    v_lshl_add_u32 v23, v22, 3, v23
    v_and_b32 v22, 1, v3
    v_lshl_add_u32 v1, v22, 2, v1
    s_lshl_b32 s52, s22, 2
    v_xor_b32 v1, s52, v1
    v_lshl_add_u32 v23, v1, 5, v23
    v_add_u32 v36, 65536, v23
    v_xor_b32 v37, 32, v36
    v_xor_b32 v38, 64, v36
    v_xor_b32 v39, 96, v36
    v_lshrrev_b32 v1, 5, v0
    v_and_b32 v22, 31, v0
    v_lshlrev_b32 v23, 8, v1
    v_lshl_add_u32 v23, v22, 1, v23
    s_lshl_b32 s52, s22, 6
    s_add_u32 s52, s52, 148480
    v_add_u32 v32, s52, v23
    s_lshl_b32 s52, s22, 2
    s_add_u32 s52, s52, 148992
    v_lshl_add_u32 v33, v1, 4, s52
    v_mov_b32 v35, 148992
    s_lshl_b32 s52, s22, 11
    s_add_u32 s52, s52, 131072
    v_lshl_add_u32 v34, v0, 2, s52
    s_mov_b32 s30, 0xcccccccc
    s_mov_b32 s31, 0xcccccccc
    v_mov_b32 v40, 0x3f803f80
    v_mov_b32 v41, 0x3f803f80
    v_mov_b32 v42, 0x3f803f80
    v_mov_b32 v43, 0x3f803f80
    s_branch L_pollq_issued
L_pollq:
    buffer_load_dwordx4 v[52:55], v186, s[44:47], s68 offen sc1
    buffer_load_dwordx4 v[56:59], v186, s[44:47], s69 offen sc1
L_pollq_issued:
L_bg_2:
    s_cmp_ge_u32 s73, 5
    s_cbranch_scc1 L_bg_2_x
    ds_read_b32 v1, v4
    s_waitcnt lgkmcnt(0)
    v_cmp_le_u32 vcc, s72, v1
    s_cmp_eq_u64 vcc, -1
    s_cbranch_scc0 L_bg_2_x
    s_cmp_lg_u32 s73, 0
    s_cbranch_scc1 L_bg_2_t0
    ds_read_b128 v[104:107], v28 offset:0
    ds_read_b128 v[108:111], v29 offset:0
    ds_read_b128 v[112:115], v30 offset:0
    ds_read_b128 v[116:119], v31 offset:0
    ds_read_b128 v[120:123], v28 offset:256
    ds_read_b128 v[124:127], v29 offset:256
    ds_read_b128 v[128:131], v30 offset:256
    ds_read_b128 v[132:135], v31 offset:256
    s_waitcnt lgkmcnt(4)
    ds_read_b128 v[136:139], v28 offset:8192
    ds_read_b128 v[140:143], v29 offset:8192
    ds_read_b128 v[144:147], v30 offset:8192
    ds_read_b128 v[148:151], v31 offset:8192
    ds_read_b128 v[152:155], v28 offset:8448
    ds_read_b128 v[156:159], v29 offset:8448
    ds_read_b128 v[160:163], v30 offset:8448
    ds_read_b128 v[164:167], v31 offset:8448
    s_mov_b32 s73, 1
    s_mov_b32 s72, 24
    s_branch L_bg_2
L_bg_2_t0:
    s_cmp_lg_u32 s73, 1
    s_cbranch_scc1 L_bg_2_t1
    ds_read_b64_tr_b16 v[192:193], v36 offset:0
    ds_read_b64_tr_b16 v[194:195], v36 offset:2048
    ds_read_b64_tr_b16 v[196:197], v37 offset:0
    ds_read_b64_tr_b16 v[198:199], v37 offset:2048
    ds_read_b64_tr_b16 v[200:201], v38 offset:0
    ds_read_b64_tr_b16 v[202:203], v38 offset:2048
    ds_read_b64_tr_b16 v[204:205], v39 offset:0
    ds_read_b64_tr_b16 v[206:207], v39 offset:2048
    s_mov_b32 s73, 2
    s_mov_b32 s72, 28
    s_branch L_bg_2
L_bg_2_t1:
    s_cmp_lg_u32 s73, 2
    s_cbranch_scc1 L_bg_2_t2
    ds_read_b64_tr_b16 v[208:209], v36 offset:16384
    ds_read_b64_tr_b16 v[210:211], v36 offset:18432
    ds_read_b64_tr_b16 v[212:213], v37 offset:16384
    ds_read_b64_tr_b16 v[214:215], v37 offset:18432
    ds_read_b64_tr_b16 v[216:217], v38 offset:16384
    ds_read_b64_tr_b16 v[218:219], v38 offset:18432
    ds_read_b64_tr_b16 v[220:221], v39 offset:16384
    ds_read_b64_tr_b16 v[222:223], v39 offset:18432
    s_mov_b32 s73, 3
    s_mov_b32 s72, 32
    s_branch L_bg_2
L_bg_2_t2:
    s_cmp_lg_u32 s73, 3
    s_cbranch_scc1 L_bg_2_t3
    ds_read_b64_tr_b16 v[224:225], v36 offset:32768
    ds_read_b64_tr_b16 v[226:227], v36 offset:34816
    ds_read_b64_tr_b16 v[228:229], v37 offset:32768
    ds_read_b64_tr_b16 v[230:231], v37 offset:34816
    ds_read_b64_tr_b16 v[232:233], v38 offset:32768
    ds_read_b64_tr_b16 v[234:235], v38 offset:34816
    ds_read_b64_tr_b16 v[236:237], v39 offset:32768
    ds_read_b64_tr_b16 v[238:239], v39 offset:34816
    s_mov_b32 s73, 4
    s_mov_b32 s72, 36
    s_branch L_bg_2
L_bg_2_t3:
    ds_read_b64_tr_b16 v[240:241], v36 offset:49152
    ds_read_b64_tr_b16 v[242:243], v36 offset:51200
    ds_read_b64_tr_b16 v[244:245], v37 offset:49152
    ds_read_b64_tr_b16 v[246:247], v37 offset:51200
    ds_read_b64_tr_b16 v[248:249], v38 offset:49152
    ds_read_b64_tr_b16 v[250:251], v38 offset:51200
    ds_read_b64_tr_b16 v[252:253], v39 offset:49152
    ds_read_b64_tr_b16 v[254:255], v39 offset:51200
    s_mov_b32 s73, 5
    s_mov_b32 s72, 40
    s_branch L_bg_2
L_bg_2_x:
    s_sub_u32 s74, s74, 1
    s_cbranch_scc1 L_pollq_done
    s_waitcnt vmcnt(0)
    v_cmp_eq_u32 s[54:55], s23, v55
    v_cmp_eq_u32 vcc, s23, v59
    s_and_b64 s[54:55], s[54:55], vcc
    s_cmp_eq_u64 s[54:55], -1
    s_cbranch_scc1 L_pollq_done
    s_add_u32 s24, s24, 1
    s_cmp_lg_u32 s24, 3
    s_cbranch_scc1 L_pollq
    s_add_u32 s68, s68, 1507328
    s_add_u32 s69, s69, 1507328
    s_branch L_pollq
L_pollq_done:
    s_waitcnt vmcnt(0)
    s_mov_b32 s52, 0x0504030c
    s_mov_b32 s53, 0x0403020c
    v_lshlrev_b32 v60, 8, v52
    v_perm_b32 v61, v53, v52, s52
    v_perm_b32 v62, v54, v53, s53
    v_and_b32 v63, 0xffffff00, v54
    v_lshlrev_b32 v64, 8, v56
    v_perm_b32 v65, v57, v56, s52
    v_perm_b32 v66, v58, v57, s53
    v_and_b32 v67, 0xffffff00, v58
    v_add_f32 v60, v60, v64
    v_add_f32 v61, v61, v65
    v_add_f32 v62, v62, v66
    v_add_f32 v63, v63, v67
    v_lshrrev_b32 v1, 5, v0
    v_and_b32 v22, 31, v0
    v_permlane32_swap_b32 v60, v61
    v_permlane32_swap_b32 v62, v63
    v_lshlrev_b32 v22, 3, v22
    v_add_f32 v60, v60, v61
    v_add_f32 v62, v62, v63
    v_lshl_add_u32 v22, v1, 1, v22
    s_lshl_b32 s55, s22, 8
    s_add_u32 s55, s55, 147456
    v_cvt_pk_bf16_f32 v60, v60, v62
    v_add_u32 v22, s55, v22
    s_lshl_b32 s55, s22, 2
    s_add_u32 s55, s55, 149520
    v_mov_b32 v1, s55
    v_mov_b32 v23, 1
    ds_write_b16 v22, v60
    ds_write_b16_d16_hi v22, v60 offset:4
    s_mov_b64 exec, 1
    ds_write_b32 v1, v23
    s_mov_b64 exec, -1
    s_and_b32 s52, s64, 1
    s_lshr_b32 s53, s64, 1
    s_and_b32 s53, s53, 1
    s_lshl_b32 s53, s53, 24
    s_or_b32 s52, s52, s53
    s_lshr_b32 s53, s64, 2
    s_and_b32 s53, s53, 1
    s_lshl_b32 s53, s53, 16
    s_lshr_b32 s54, s64, 3
    s_and_b32 s54, s54, 1
    s_lshl_b32 s54, s54, 8
    v_xor_b32 v60, s52, v52
    v_xor_b32 v61, s52, v56
    v_xor_b32 v62, s53, v53
    v_xor_b32 v63, s53, v57
    v_xor_b32 v64, s54, v54
    v_xor_b32 v65, s54, v58
    v_or_b32 v60, v60, v61
    v_or_b32 v62, v62, v63
    v_or_b32 v64, v64, v65
    v_and_b32 v60, 0x01000001, v60
    v_and_b32 v62, 0x00010000, v62
    v_and_b32 v64, 0x00000100, v64
    v_or3_b32 v60, v60, v62, v64
    v_cmp_eq_u32 vcc, 0, v60
    v_add_u32 v1, 96, v1
    s_cmp_eq_u64 vcc, -1
    s_cselect_b32 s54, 3, 1
    v_mov_b32 v23, s54
    s_mov_b64 exec, 1
    ds_write_b32 v1, v23
    s_mov_b64 exec, -1
L_fqw:
    ds_read_b32 v22, v5
    s_waitcnt lgkmcnt(0)
    v_cmp_ne_u32 vcc, 0, v22
    s_cmp_eq_u64 vcc, -1
    s_cbranch_scc1 L_fqw_ok
L_bg_3:
    s_cmp_ge_u32 s73, 5
    s_cbranch_scc1 L_bg_3_x
    ds_read_b32 v1, v4
    s_waitcnt lgkmcnt(0)
    v_cmp_le_u32 vcc, s72, v1
    s_cmp_eq_u64 vcc, -1
    s_cbranch_scc0 L_bg_3_x
    s_cmp_lg_u32 s73, 0
    s_cbranch_scc1 L_bg_3_t0
    ds_read_b128 v[104:107], v28 offset:0
    ds_read_b128 v[108:111], v29 offset:0
    ds_read_b128 v[112:115], v30 offset:0
    ds_read_b128 v[116:119], v31 offset:0
    ds_read_b128 v[120:123], v28 offset:256
    ds_read_b128 v[124:127], v29 offset:256
    ds_read_b128 v[128:131], v30 offset:256
    ds_read_b128 v[132:135], v31 offset:256
    s_waitcnt lgkmcnt(4)
    ds_read_b128 v[136:139], v28 offset:8192
    ds_read_b128 v[140:143], v29 offset:8192
    ds_read_b128 v[144:147], v30 offset:8192
    ds_read_b128 v[148:151], v31 offset:8192
    ds_read_b128 v[152:155], v28 offset:8448
    ds_read_b128 v[156:159], v29 offset:8448
    ds_read_b128 v[160:163], v30 offset:8448
    ds_read_b128 v[164:167], v31 offset:8448
    s_mov_b32 s73, 1
    s_mov_b32 s72, 24
    s_branch L_bg_3_x
L_bg_3_t0:
    s_cmp_lg_u32 s73, 1
    s_cbranch_scc1 L_bg_3_t1
    ds_read_b64_tr_b16 v[192:193], v36 offset:0
    ds_read_b64_tr_b16 v[194:195], v36 offset:2048
    ds_read_b64_tr_b16 v[196:197], v37 offset:0
    ds_read_b64_tr_b16 v[198:199], v37 offset:2048
    ds_read_b64_tr_b16 v[200:201], v38 offset:0
    ds_read_b64_tr_b16 v[202:203], v38 offset:2048
    ds_read_b64_tr_b16 v[204:205], v39 offset:0
    ds_read_b64_tr_b16 v[206:207], v39 offset:2048
    s_mov_b32 s73, 2
    s_mov_b32 s72, 28
    s_branch L_bg_3_x
L_bg_3_t1:
    s_cmp_lg_u32 s73, 2
    s_cbranch_scc1 L_bg_3_t2
    ds_read_b64_tr_b16 v[208:209], v36 offset:16384
    ds_read_b64_tr_b16 v[210:211], v36 offset:18432
    ds_read_b64_tr_b16 v[212:213], v37 offset:16384
    ds_read_b64_tr_b16 v[214:215], v37 offset:18432
    ds_read_b64_tr_b16 v[216:217], v38 offset:16384
    ds_read_b64_tr_b16 v[218:219], v38 offset:18432
    ds_read_b64_tr_b16 v[220:221], v39 offset:16384
    ds_read_b64_tr_b16 v[222:223], v39 offset:18432
    s_mov_b32 s73, 3
    s_mov_b32 s72, 32
    s_branch L_bg_3_x
L_bg_3_t2:
    s_cmp_lg_u32 s73, 3
    s_cbranch_scc1 L_bg_3_t3
    ds_read_b64_tr_b16 v[224:225], v36 offset:32768
    ds_read_b64_tr_b16 v[226:227], v36 offset:34816
    ds_read_b64_tr_b16 v[228:229], v37 offset:32768
    ds_read_b64_tr_b16 v[230:231], v37 offset:34816
    ds_read_b64_tr_b16 v[232:233], v38 offset:32768
    ds_read_b64_tr_b16 v[234:235], v38 offset:34816
    ds_read_b64_tr_b16 v[236:237], v39 offset:32768
    ds_read_b64_tr_b16 v[238:239], v39 offset:34816
    s_mov_b32 s73, 4
    s_mov_b32 s72, 36
    s_branch L_bg_3_x
L_bg_3_t3:
    ds_read_b64_tr_b16 v[240:241], v36 offset:49152
    ds_read_b64_tr_b16 v[242:243], v36 offset:51200
    ds_read_b64_tr_b16 v[244:245], v37 offset:49152
    ds_read_b64_tr_b16 v[246:247], v37 offset:51200
    ds_read_b64_tr_b16 v[248:249], v38 offset:49152
    ds_read_b64_tr_b16 v[250:251], v38 offset:51200
    ds_read_b64_tr_b16 v[252:253], v39 offset:49152
    ds_read_b64_tr_b16 v[254:255], v39 offset:51200
    s_mov_b32 s73, 5
    s_mov_b32 s72, 40
    s_branch L_bg_3_x
L_bg_3_x:
    s_branch L_fqw
L_fqw_ok:
    ds_read_b128 v[72:75], v26 offset:0
    ds_read_b128 v[76:79], v26 offset:64
    ds_read_b128 v[80:83], v26 offset:128
    ds_read_b128 v[84:87], v26 offset:192
    ds_read_b128 v[88:91], v26 offset:256
    ds_read_b128 v[92:95], v26 offset:320
    ds_read_b128 v[96:99], v26 offset:384
    ds_read_b128 v[100:103], v26 offset:448
    s_cmp_gt_u32 s73, 0
    s_cbranch_scc1 L_ens_4
L_e_5:
    ds_read_b32 v1, v4 offset:0
    s_waitcnt lgkmcnt(0)
    v_cmp_le_u32 vcc, s72, v1
    s_cmp_eq_u64 vcc, -1
    s_cbranch_scc1 L_e_5_ok
    s_sleep 1
    s_branch L_e_5
L_e_5_ok:
    ds_read_b128 v[104:107], v28 offset:0
    ds_read_b128 v[108:111], v29 offset:0
    ds_read_b128 v[112:115], v30 offset:0
    ds_read_b128 v[116:119], v31 offset:0
    ds_read_b128 v[120:123], v28 offset:256
    ds_read_b128 v[124:127], v29 offset:256
    ds_read_b128 v[128:131], v30 offset:256
    ds_read_b128 v[132:135], v31 offset:256
    s_waitcnt lgkmcnt(4)
    ds_read_b128 v[136:139], v28 offset:8192
    ds_read_b128 v[140:143], v29 offset:8192
    ds_read_b128 v[144:147], v30 offset:8192
    ds_read_b128 v[148:151], v31 offset:8192
    ds_read_b128 v[152:155], v28 offset:8448
    ds_read_b128 v[156:159], v29 offset:8448
    ds_read_b128 v[160:163], v30 offset:8448
    ds_read_b128 v[164:167], v31 offset:8448
    s_mov_b32 s73, 1
    s_mov_b32 s72, 24
L_ens_4:
    s_waitcnt lgkmcnt(0)
    v_mfma_f32_16x16x32_bf16 v[168:171], v[72:75], v[104:107], 0
    v_mfma_f32_16x16x32_bf16 v[172:175], v[72:75], v[136:139], 0
    v_mfma_f32_16x16x32_bf16 v[168:171], v[76:79], v[108:111], v[168:171]
    v_mfma_f32_16x16x32_bf16 v[172:175], v[76:79], v[140:143], v[172:175]
    v_mfma_f32_16x16x32_bf16 v[168:171], v[80:83], v[112:115], v[168:171]
    v_mfma_f32_16x16x32_bf16 v[172:175], v[80:83], v[144:147], v[172:175]
    v_mfma_f32_16x16x32_bf16 v[168:171], v[84:87], v[116:119], v[168:171]
    v_mfma_f32_16x16x32_bf16 v[172:175], v[84:87], v[148:151], v[172:175]
    v_mfma_f32_16x16x32_bf16 v[168:171], v[88:91], v[120:123], v[168:171]
    v_mfma_f32_16x16x32_bf16 v[172:175], v[88:91], v[152:155], v[172:175]
    v_mfma_f32_16x16x32_bf16 v[168:171], v[92:95], v[124:127], v[168:171]
    v_mfma_f32_16x16x32_bf16 v[172:175], v[92:95], v[156:159], v[172:175]
    v_mfma_f32_16x16x32_bf16 v[168:171], v[96:99], v[128:131], v[168:171]
    v_mfma_f32_16x16x32_bf16 v[172:175], v[96:99], v[160:163], v[172:175]
    v_mfma_f32_16x16x32_bf16 v[168:171], v[100:103], v[132:135], v[168:171]
    v_mfma_f32_16x16x32_bf16 v[172:175], v[100:103], v[164:167], v[172:175]
    s_mov_b32 s52, 0x3db8aa3b
    s_mov_b32 s54, 1
    s_mov_b32 s55, 1
    s_lshl_b32 s53, s22, 2
    s_add_u32 s53, s53, 149536
    v_mov_b32 v1, s53
    v_mov_b32 v72, 1
    s_nop 0
    v_cndmask_b32 v22, v168, v169, s[60:61]
    v_cndmask_b32 v23, v172, v173, s[60:61]
    v_cndmask_b32 v22, v22, v23, s[58:59]
    v_cvt_pk_bf16_f32 v22, v22, v22
    v_lshlrev_b32 v22, 16, v22
    s_nop 1
    v_max_f32_dpp v23, v22, v22 quad_perm:[1,0,3,2] row_mask:0xf bank_mask:0xf
    s_nop 1
    v_max_f32_dpp v23, v23, v23 quad_perm:[2,3,0,1] row_mask:0xf bank_mask:0xf
    s_nop 1
    v_max_f32_dpp v23, v23, v23 row_half_mirror row_mask:0xf bank_mask:0xf
    s_nop 1
    v_max_f32_dpp v23, v23, v23 row_mirror row_mask:0xf bank_mask:0xf
    v_mov_b32 v73, v23
    s_nop 1
    v_permlane16_swap_b32 v23, v73
    s_nop 0
    v_max_f32 v23, v23, v73
    s_mov_b64 exec, s[54:55]
    ds_write_b32 v33, v23
    s_mov_b64 exec, 1
    ds_write_b32 v1, v72
    s_mov_b64 exec, -1
L_mw:
    ds_read_b32 v73, v6
    ds_read_b128 v[76:79], v35
    ds_read_b128 v[80:83], v35 offset:16
    s_waitcnt lgkmcnt(0)
    v_cmp_ne_u32 vcc, 0, v73
    s_cmp_eq_u64 vcc, -1
    s_cbranch_scc0 L_mw
    v_max3_f32 v76, v76, v77, v78
    v_max3_f32 v80, v80, v81, v82
    v_max_f32 v76, v76, v79
    v_max_f32 v80, v80, v83
    v_mul_f32 v76, s52, v76
    v_mul_f32 v80, s52, v80
    v_cndmask_b32 v77, v76, v80, s[60:61]
    v_fma_f32 v22, v22, s52, -v77
    v_exp_f32 v22, v22
    v_add_u32 v1, 16, v1
    v_cndmask_b32 v126, v76, v80, s[30:31]
    v_cvt_pk_bf16_f32 v22, v22, v22
    ds_write_b16 v32, v22
    s_mov_b64 exec, 1
    ds_write_b32 v1, v72
    s_mov_b64 exec, -1
    v_mov_b32 v127, s23
L_pw:
    ds_read_b32 v73, v6 offset:16
    ds_read_b32 v74, v5 offset:96
    ds_read_b128 v[52:55], v27 offset:0
    ds_read_b128 v[56:59], v27 offset:64
    ds_read_b128 v[60:63], v27 offset:128
    ds_read_b128 v[64:67], v27 offset:192
    s_waitcnt lgkmcnt(0)
    v_min_u32 v75, v73, v74
    v_cmp_ne_u32 vcc, 0, v75
    s_cmp_eq_u64 vcc, -1
    s_cbranch_scc0 L_pw
    v_cmp_eq_u32 vcc, 3, v74
    s_cmp_eq_u64 vcc, -1
    s_cselect_b32 s65, 1, 0
    s_cmp_gt_u32 s73, 1
    s_cbranch_scc1 L_ens_6
L_e_7:
    ds_read_b32 v1, v4 offset:0
    s_waitcnt lgkmcnt(0)
    v_cmp_le_u32 vcc, s72, v1
    s_cmp_eq_u64 vcc, -1
    s_cbranch_scc1 L_e_7_ok
    s_sleep 1
    s_branch L_e_7
L_e_7_ok:
    ds_read_b64_tr_b16 v[192:193], v36 offset:0
    ds_read_b64_tr_b16 v[194:195], v36 offset:2048
    ds_read_b64_tr_b16 v[196:197], v37 offset:0
    ds_read_b64_tr_b16 v[198:199], v37 offset:2048
    ds_read_b64_tr_b16 v[200:201], v38 offset:0
    ds_read_b64_tr_b16 v[202:203], v38 offset:2048
    ds_read_b64_tr_b16 v[204:205], v39 offset:0
    ds_read_b64_tr_b16 v[206:207], v39 offset:2048
    s_mov_b32 s73, 2
    s_mov_b32 s72, 28
L_ens_6:
    s_waitcnt lgkmcnt(0)
    v_mfma_f32_16x16x32_bf16 v[160:163], v[52:55], v[40:43], 0
    v_mfma_f32_16x16x32_bf16 v[144:147], v[52:55], v[192:195], 0
    v_mfma_f32_16x16x32_bf16 v[148:151], v[52:55], v[196:199], 0
    v_mfma_f32_16x16x32_bf16 v[152:155], v[52:55], v[200:203], 0
    v_mfma_f32_16x16x32_bf16 v[156:159], v[52:55], v[204:207], 0
    s_cmp_gt_u32 s73, 2
    s_cbranch_scc1 L_ens_8
L_e_9:
    ds_read_b32 v1, v4 offset:0
    s_waitcnt lgkmcnt(0)
    v_cmp_le_u32 vcc, s72, v1
    s_cmp_eq_u64 vcc, -1
    s_cbranch_scc1 L_e_9_ok
    s_sleep 1
    s_branch L_e_9
L_e_9_ok:
    ds_read_b64_tr_b16 v[208:209], v36 offset:16384
    ds_read_b64_tr_b16 v[210:211], v36 offset:18432
    ds_read_b64_tr_b16 v[212:213], v37 offset:16384
    ds_read_b64_tr_b16 v[214:215], v37 offset:18432
    ds_read_b64_tr_b16 v[216:217], v38 offset:16384
    ds_read_b64_tr_b16 v[218:219], v38 offset:18432
    ds_read_b64_tr_b16 v[220:221], v39 offset:16384
    ds_read_b64_tr_b16 v[222:223], v39 offset:18432
    s_mov_b32 s73, 3
    s_mov_b32 s72, 32
L_ens_8:
    s_waitcnt lgkmcnt(0)
    v_mfma_f32_16x16x32_bf16 v[160:163], v[56:59], v[40:43], v[160:163]
    v_mfma_f32_16x16x32_bf16 v[144:147], v[56:59], v[208:211], v[144:147]
    v_mfma_f32_16x16x32_bf16 v[148:151], v[56:59], v[212:215], v[148:151]
    v_mfma_f32_16x16x32_bf16 v[152:155], v[56:59], v[216:219], v[152:155]
    v_mfma_f32_16x16x32_bf16 v[156:159], v[56:59], v[220:223], v[156:159]
    s_cmp_gt_u32 s73, 3
    s_cbranch_scc1 L_ens_10
L_e_11:
    ds_read_b32 v1, v4 offset:0
    s_waitcnt lgkmcnt(0)
    v_cmp_le_u32 vcc, s72, v1
    s_cmp_eq_u64 vcc, -1
    s_cbranch_scc1 L_e_11_ok
    s_sleep 1
    s_branch L_e_11
L_e_11_ok:
    ds_read_b64_tr_b16 v[224:225], v36 offset:32768
    ds_read_b64_tr_b16 v[226:227], v36 offset:34816
    ds_read_b64_tr_b16 v[228:229], v37 offset:32768
    ds_read_b64_tr_b16 v[230:231], v37 offset:34816
    ds_read_b64_tr_b16 v[232:233], v38 offset:32768
    ds_read_b64_tr_b16 v[234:235], v38 offset:34816
    ds_read_b64_tr_b16 v[236:237], v39 offset:32768
    ds_read_b64_tr_b16 v[238:239], v39 offset:34816
    s_mov_b32 s73, 4
    s_mov_b32 s72, 36
L_ens_10:
    s_waitcnt lgkmcnt(0)
    v_mfma_f32_16x16x32_bf16 v[160:163], v[60:63], v[40:43], v[160:163]
    v_mfma_f32_16x16x32_bf16 v[144:147], v[60:63], v[224:227], v[144:147]
    v_mfma_f32_16x16x32_bf16 v[148:151], v[60:63], v[228:231], v[148:151]
    v_mfma_f32_16x16x32_bf16 v[152:155], v[60:63], v[232:235], v[152:155]
    v_mfma_f32_16x16x32_bf16 v[156:159], v[60:63], v[236:239], v[156:159]
    v_mfma_f32_16x16x32_bf16 v[160:163], v[64:67], v[40:43], v[160:163]
    s_nop 7
    v_cndmask_b32 v1, v160, v161, s[30:31]
    v_cndmask_b32 v126, v126, v1, s[62:63]
    s_barrier
    s_cmp_gt_u32 s73, 4
    s_cbranch_scc1 L_v3_12_ok
    ds_read_b64_tr_b16 v[240:241], v36 offset:49152
    ds_read_b64_tr_b16 v[242:243], v36 offset:51200
    ds_read_b64_tr_b16 v[244:245], v37 offset:49152
    ds_read_b64_tr_b16 v[246:247], v37 offset:51200
    ds_read_b64_tr_b16 v[248:249], v38 offset:49152
    ds_read_b64_tr_b16 v[250:251], v38 offset:51200
    ds_read_b64_tr_b16 v[252:253], v39 offset:49152
    ds_read_b64_tr_b16 v[254:255], v39 offset:51200
L_v3_12_ok:
    s_waitcnt lgkmcnt(6)
    v_mfma_f32_16x16x32_bf16 v[144:147], v[64:67], v[240:243], v[144:147]
    s_waitcnt lgkmcnt(4)
    v_mfma_f32_16x16x32_bf16 v[148:151], v[64:67], v[244:247], v[148:151]
    s_waitcnt lgkmcnt(2)
    v_mfma_f32_16x16x32_bf16 v[152:155], v[64:67], v[248:251], v[152:155]
    s_waitcnt lgkmcnt(0)
    v_mfma_f32_16x16x32_bf16 v[156:159], v[64:67], v[252:255], v[156:159]
    s_nop 5
    v_cndmask_b32 v22, v144, v148, s[58:59]
    v_cndmask_b32 v23, v145, v149, s[58:59]
    v_cndmask_b32 v72, v152, v156, s[58:59]
    v_cndmask_b32 v73, v153, v157, s[58:59]
    v_cndmask_b32 v124, v22, v72, s[60:61]
    v_cndmask_b32 v125, v23, v73, s[60:61]
    s_cmp_eq_u32 s65, 0
    s_cbranch_scc1 L_pub_remote
    buffer_store_dwordx4 v[124:127], v184, s[44:47], s56 offen
    s_branch L_pub_done
L_pub_remote:
    buffer_store_dwordx4 v[124:127], v184, s[44:47], s56 offen sc1
L_pub_done:
    s_mov_b32 s54, 0x05040100
    s_mov_b32 s55, 0x07060302
    s_lshl_b32 s52, s22, 9
    s_add_u32 s52, s52, 0
    v_lshl_add_u32 v104, v0, 3, s52
    v_and_b32 v1, 3, v0
    v_max_u32 v1, 1, v1
    v_lshlrev_b32 v1, 2, v1
    v_add_u32 v105, 149568, v1
    v_lshrrev_b32 v1, 3, v0
    v_lshlrev_b32 v1, 13, v1
    v_and_b32 v22, 7, v0
    v_lshl_add_u32 v106, v22, 4, v1
    s_lshl_b32 s52, s76, 16
    s_lshl_b32 s53, s20, 3
    s_add_u32 s53, s53, s75
    s_lshl_b32 s53, s53, 7
    s_add_u32 s52, s52, s53
    s_add_u32 s24, s52, 1310720
    s_cmp_eq_u32 s76, 3
    s_cselect_b32 s27, 0, -1
    s_mov_b32 s26, -1
    s_lshl_b32 s52, s20, 3
    s_lshl_b64 s[28:29], 0xff, s52
    s_cmp_eq_u32 s65, 0
    s_cselect_b64 s[28:29], 0, s[28:29]
    s_and_b64 s[28:29], s[28:29], s[26:27]
    v_mov_b32 v161, s23
    v_mov_b32 v163, s23
    s_lshl_b32 s52, s22, 2
    s_add_u32 s52, s52, 149568
    v_mov_b32 v107, s52
    v_mov_b32 v108, 1
    s_waitcnt vmcnt(0)
    s_mov_b32 s74, 200000
    s_mov_b32 s36, 0
L_poll1:
    buffer_load_dwordx4 v[128:131], v7, s[44:47], s77 offen offset:0 sc1
    buffer_load_dwordx4 v[132:135], v7, s[44:47], s77 offen offset:1024 sc1
    buffer_load_dwordx4 v[136:139], v7, s[44:47], s77 offen offset:2048 sc1
    buffer_load_dwordx4 v[140:143], v7, s[44:47], s77 offen offset:3072 sc1
    s_cmp_lg_u32 s36, 0
    s_cbranch_scc1 L_poll1_issued
    ds_read_b32 v1, v4
    s_waitcnt lgkmcnt(0)
    v_cmp_le_u32 vcc, 40, v1
    s_cmp_eq_u64 vcc, -1
    s_cbranch_scc0 L_poll1_issued
    ds_read2st64_b32 v[72:73], v34 offset0:0 offset1:1
    ds_read2st64_b32 v[74:75], v34 offset0:2 offset1:3
    ds_read2st64_b32 v[76:77], v34 offset0:4 offset1:5
    ds_read2st64_b32 v[78:79], v34 offset0:6 offset1:7
    ds_read2st64_b32 v[80:81], v34 offset0:32 offset1:33
    ds_read2st64_b32 v[82:83], v34 offset0:34 offset1:35
    ds_read2st64_b32 v[84:85], v34 offset0:36 offset1:37
    ds_read2st64_b32 v[86:87], v34 offset0:38 offset1:39
    s_mov_b32 s36, 1
L_poll1_issued:
    s_sub_u32 s74, s74, 1
    s_cselect_b32 s25, 1, 0
    s_waitcnt vmcnt(0)
    v_max3_f32 v144, v130, v134, v138
    v_max_f32 v144, v144, v142
    v_cmp_eq_u32 s[52:53], s23, v131
    v_cmp_eq_u32 vcc, s23, v135
    v_max_f32_dpp v144, v144, v144 row_ror:8 row_mask:0xf bank_mask:0xf
    s_and_b64 s[52:53], s[52:53], vcc
    v_mov_b32 v148, v144
    v_cmp_eq_u32 vcc, s23, v139
    s_and_b64 s[52:53], s[52:53], vcc
    v_permlane16_swap_b32 v144, v148
    v_cmp_eq_u32 vcc, s23, v143
    v_max_f32 v144, v144, v148
    s_and_b64 s[52:53], s[52:53], vcc
    v_mov_b32 v148, v144
    s_cmp_eq_u64 s[52:53], -1
    s_cbranch_scc1 L_poll1_done
    s_cmp_eq_u32 s25, 0
    s_cbranch_scc1 L_poll1
L_poll1_done:
    v_permlane32_swap_b32 v144, v148
    s_cmp_lg_u32 s36, 0
    s_cbranch_scc1 L_wo_have
L_wo_13:
    ds_read_b32 v1, v4 offset:0
    s_waitcnt lgkmcnt(0)
    v_cmp_le_u32 vcc, 40, v1
    s_cmp_eq_u64 vcc, -1
    s_cbranch_scc0 L_wo_13
    ds_read2st64_b32 v[72:73], v34 offset0:0 offset1:1
    ds_read2st64_b32 v[74:75], v34 offset0:2 offset1:3
    ds_read2st64_b32 v[76:77], v34 offset0:4 offset1:5
    ds_read2st64_b32 v[78:79], v34 offset0:6 offset1:7
    ds_read2st64_b32 v[80:81], v34 offset0:32 offset1:33
    ds_read2st64_b32 v[82:83], v34 offset0:34 offset1:35
    ds_read2st64_b32 v[84:85], v34 offset0:36 offset1:37
    ds_read2st64_b32 v[86:87], v34 offset0:38 offset1:39
L_wo_have:
    v_max_f32 v144, v144, v148
    v_sub_f32 v152, v130, v144
    v_sub_f32 v153, v134, v144
    v_sub_f32 v154, v138, v144
    v_sub_f32 v155, v142, v144
    v_exp_f32 v152, v152
    v_exp_f32 v153, v153
    v_exp_f32 v154, v154
    v_exp_f32 v155, v155
    s_waitcnt lgkmcnt(0)
    v_mul_f32_dpp v145, v152, v128 quad_perm:[0,0,0,0] row_mask:0xf bank_mask:0xf
    v_mul_f32_dpp v146, v152, v129 quad_perm:[2,2,2,2] row_mask:0xf bank_mask:0xf
    v_mul_f32_dpp v147, v152, v130 quad_perm:[0,0,2,2] row_mask:0xf bank_mask:0xf
    v_fmac_f32_dpp v145, v153, v132 quad_perm:[0,0,0,0] row_mask:0xf bank_mask:0xf
    v_fmac_f32_dpp v146, v153, v133 quad_perm:[2,2,2,2] row_mask:0xf bank_mask:0xf
    v_fmac_f32_dpp v147, v153, v134 quad_perm:[0,0,2,2] row_mask:0xf bank_mask:0xf
    v_fmac_f32_dpp v145, v154, v136 quad_perm:[0,0,0,0] row_mask:0xf bank_mask:0xf
    v_fmac_f32_dpp v146, v154, v137 quad_perm:[2,2,2,2] row_mask:0xf bank_mask:0xf
    v_fmac_f32_dpp v147, v154, v138 quad_perm:[0,0,2,2] row_mask:0xf bank_mask:0xf
    v_fmac_f32_dpp v145, v155, v140 quad_perm:[0,0,0,0] row_mask:0xf bank_mask:0xf
    v_fmac_f32_dpp v146, v155, v141 quad_perm:[2,2,2,2] row_mask:0xf bank_mask:0xf
    v_fmac_f32_dpp v147, v155, v142 quad_perm:[0,0,2,2] row_mask:0xf bank_mask:0xf
    v_mov_b32 v148, v147
    v_perm_b32 v88, v73, v72, s54
    v_permlane32_swap_b32 v145, v146
    v_permlane32_swap_b32 v147, v148
    v_add_f32 v145, v145, v146
    v_add_f32 v147, v147, v148
    v_perm_b32 v89, v73, v72, s55
    v_perm_b32 v90, v75, v74, s54
    v_permlane16_swap_b32 v145, v147
    v_perm_b32 v91, v75, v74, s55
    v_add_f32 v145, v145, v147
    v_perm_b32 v92, v77, v76, s54
    v_perm_b32 v93, v77, v76, s55
    v_add_f32_dpp v145, v145, v145 row_ror:8 row_mask:0xf bank_mask:0xf
    v_perm_b32 v94, v79, v78, s54
    v_perm_b32 v95, v79, v78, s55
    v_mov_b32_dpp v148, v145 quad_perm:[1,1,3,3] row_mask:0xf bank_mask:0xf
    v_rcp_f32 v147, v145
    v_cvt_pk_bf16_f32 v146, v145, v148
    v_perm_b32 v96, v81, v80, s54
    v_readlane_b32 s66, v146, 0
    v_readlane_b32 s70, v146, 32
    v_readlane_b32 s67, v146, 2
    v_readlane_b32 s71, v146, 34
    v_readlane_b32 s68, v146, 4
    v_readlane_b32 s72, v146, 36
    v_readlane_b32 s69, v146, 6
    v_readlane_b32 s73, v146, 38
    v_readlane_b32 s52, v147, 17
    v_readlane_b32 s53, v147, 19
    v_perm_b32 v97, v81, v80, s55
    v_perm_b32 v98, v83, v82, s54
    v_perm_b32 v99, v83, v82, s55
    v_perm_b32 v100, v85, v84, s54
    v_perm_b32 v101, v85, v84, s55
    v_perm_b32 v102, v87, v86, s54
    v_perm_b32 v103, v87, v86, s55
    v_dot2_f32_bf16 v152, s66, v88, 0
    v_dot2_f32_bf16 v153, s66, v89, 0
    v_dot2_f32_bf16 v154, s70, v96, 0
    v_dot2_f32_bf16 v155, s70, v97, 0
    v_dot2_f32_bf16 v152, s67, v90, v152
    v_dot2_f32_bf16 v153, s67, v91, v153
    v_dot2_f32_bf16 v154, s71, v98, v154
    v_dot2_f32_bf16 v155, s71, v99, v155
    v_dot2_f32_bf16 v152, s68, v92, v152
    v_dot2_f32_bf16 v153, s68, v93, v153
    v_dot2_f32_bf16 v154, s72, v100, v154
    v_dot2_f32_bf16 v155, s72, v101, v155
    v_dot2_f32_bf16 v152, s69, v94, v152
    v_dot2_f32_bf16 v153, s69, v95, v153
    v_dot2_f32_bf16 v154, s73, v102, v154
    v_dot2_f32_bf16 v155, s73, v103, v155
    s_nop 0
    v_mul_f32 v156, s52, v152
    v_mul_f32 v157, s52, v153
    s_nop 0
    v_fmac_f32 v156, s53, v154
    v_fmac_f32 v157, s53, v155
    s_cmp_eq_u32 s22, 0
    s_cbranch_scc1 L_red0
    ds_write_b64 v104, v[156:157]
    s_mov_b64 exec, 1
    ds_write_b32 v107, v108
    s_mov_b64 exec, -1
    s_cmp_ge_u32 s2, 28
    s_cbranch_scc1 L_fin
    s_branch L_final
L_red0:
    v_lshlrev_b32 v1, 3, v0
L_redw:
    ds_read_b32 v22, v105
    ds_read_b64 v[152:153], v1 offset:512
    ds_read_b64 v[154:155], v1 offset:1024
    ds_read_b64 v[158:159], v1 offset:1536
    s_waitcnt lgkmcnt(0)
    v_cmp_ne_u32 vcc, 0, v22
    s_cmp_eq_u64 vcc, -1
    s_cbranch_scc0 L_redw
    v_add_f32 v156, v156, v152
    v_add_f32 v157, v157, v153
    v_add_f32 v154, v154, v158
    v_add_f32 v155, v155, v159
    v_add_f32 v160, v156, v154
    v_add_f32 v162, v157, v155
    s_andn2_b64 exec, s[26:27], s[28:29]
    buffer_store_dwordx4 v[160:163], v106, s[44:47], s24 offen sc1
    s_mov_b64 exec, s[28:29]
    s_cbranch_execz L_noloc
    buffer_store_dwordx4 v[160:163], v106, s[44:47], s24 offen
L_noloc:
    s_mov_b64 exec, -1
    s_cmp_ge_u32 s2, 28
    s_cbranch_scc1 L_fin
L_final:
    s_lshl_b32 s52, s2, 13
    s_lshl_b32 s53, s22, 11
    s_add_u32 s52, s52, s53
    s_add_u32 s52, s52, 1310720
    v_and_b32 v1, 7, v0
    v_lshlrev_b32 v1, 3, v1
    v_lshrrev_b32 v22, 5, v0
    v_lshl_add_u32 v23, v22, 2, v1
    s_lshl_b32 s53, s22, 6
    s_add_u32 s53, s53, 4096
    v_add_u32 v23, s53, v23
    v_add_u32 v107, 32, v107
    v_add_u32 v105, 32, v105
    s_mov_b32 s54, 0xff
    s_mov_b32 s55, 0xff
    s_mov_b32 s74, 200000
    s_waitcnt vmcnt(0)
    s_barrier
L_poll2:
    buffer_load_dwordx4 v[128:131], v7, s[44:47], s52 offen sc1
    buffer_load_dwordx4 v[132:135], v7, s[44:47], s52 offen offset:1024 sc1
    s_sub_u32 s74, s74, 1
    s_cselect_b32 s25, 1, 0
    s_waitcnt vmcnt(0)
    v_add_f32 v140, v128, v132
    v_add_f32 v141, v130, v134
    v_cmp_eq_u32 s[26:27], s23, v129
    v_cmp_eq_u32 vcc, s23, v131
    v_permlane32_swap_b32 v140, v141
    s_and_b64 s[26:27], s[26:27], vcc
    v_add_f32 v140, v140, v141
    v_cmp_eq_u32 vcc, s23, v133
    v_mov_b32 v141, v140
    s_and_b64 s[26:27], s[26:27], vcc
    v_cmp_eq_u32 vcc, s23, v135
    v_permlane16_swap_b32 v140, v141
    s_and_b64 s[26:27], s[26:27], vcc
    v_add_f32 v140, v140, v141
    s_cmp_eq_u64 s[26:27], -1
    s_cbranch_scc1 L_poll2_done
    s_cmp_eq_u32 s25, 0
    s_cbranch_scc1 L_poll2
L_poll2_done:
    v_add_f32_dpp v140, v140, v140 row_ror:8 row_mask:0xf bank_mask:0xf
    s_mov_b64 exec, s[54:55]
    ds_write_b32 v23, v140
    s_cmp_eq_u32 s22, 0
    s_cbranch_scc1 L_fin0
    s_mov_b64 exec, 1
    ds_write_b32 v107, v108
    s_branch L_fin
L_fin0:
    s_mov_b64 exec, -1
    s_lshl_b32 s52, s2, 5
    v_lshlrev_b32 v22, 2, v0
L_finw:
    ds_read_b32 v23, v105
    ds_read_b64 v[140:141], v1 offset:4096
    ds_read_b64 v[142:143], v1 offset:4160
    ds_read_b64 v[144:145], v1 offset:4224
    ds_read_b64 v[146:147], v1 offset:4288
    s_waitcnt lgkmcnt(0)
    v_cmp_ne_u32 vcc, 0, v23
    s_cmp_eq_u64 vcc, -1
    s_cbranch_scc0 L_finw
    v_add_f32 v140, v140, v142
    v_add_f32 v141, v141, v143
    v_add_f32 v144, v144, v146
    v_add_f32 v145, v145, v147
    v_add_f32 v140, v140, v144
    v_add_f32 v141, v141, v145
    v_cvt_pk_bf16_f32 v140, v140, v141
    s_mov_b64 exec, 0xff
    buffer_store_dword v140, v22, s[48:51], s52 offen
    s_cmp_lg_u32 s2, 0
    s_cbranch_scc1 L_fin
    s_mov_b64 exec, 1
    v_mov_b32 v2, 0
    v_mov_b32 v3, s23
    buffer_store_dword v3, v2, s[44:47], 0 offen sc1
L_fin:
    s_mov_b64 exec, -1
    s_endpgm
L_loader:
    s_setprio 0
    s_sub_u32 s66, s22, 4
    v_lshrrev_b32 v1, 3, v0
    v_lshlrev_b32 v2, 13, v1
    v_and_b32 v3, 7, v0
    v_lshrrev_b32 v13, 4, v0
    v_and_b32 v13, 1, v13
    v_lshlrev_b32 v13, 1, v13
    v_xor_b32 v3, v3, v13
    s_and_b32 s52, s66, 1
    s_lshl_b32 s52, s52, 2
    v_xor_b32 v3, s52, v3
    v_lshl_add_u32 v8, v3, 4, v2
    s_lshr_b32 s53, s21, 3
    s_mul_i32 s53, s53, 917504
    s_lshl_b32 s54, s20, 10
    s_add_u32 s53, s53, s54
    s_and_b32 s54, s21, 7
    s_lshl_b32 s54, s54, 7
    s_add_u32 s53, s53, s54
    s_lshl_b32 s54, s66, 16
    s_add_u32 s67, s53, s54
    s_lshl_b32 s56, s66, 10
    s_add_u32 s57, s56, 131072
    s_mov_b32 m0, s57
    v_lshrrev_b32 v1, 5, v0
    v_and_b32 v2, 31, v0
    v_xor_b32 v3, v2, v1
    s_lshl_b32 s52, s66, 1
    v_xor_b32 v3, s52, v3
    v_lshlrev_b32 v3, 4, v3
    v_lshl_add_u32 v4, v1, 9, v3
    v_xor_b32 v5, 128, v4
    s_waitcnt lgkmcnt(0)
    s_mov_b32 s32, s10
    s_and_b32 s33, s11, 0xffff
    s_mov_b32 s34, 3670016
    s_mov_b32 s35, 0x20000
    buffer_load_dwordx4 v8, s[32:35], s67 offen nt lds
    s_add_u32 m0, m0, 4096
    s_add_u32 s67, s67, 262144
    s_add_u32 s24, s6, s68
    s_addc_u32 s25, s7, 0
    s_and_b32 s25, s25, 0xffff
    s_mov_b32 s26, 2097152
    s_mov_b32 s27, 0x20000
    buffer_load_dwordx4 v8, s[32:35], s67 offen nt lds
    s_add_u32 m0, m0, 4096
    s_add_u32 s67, s67, 262144
    buffer_load_dwordx4 v8, s[32:35], s67 offen nt lds
    s_add_u32 m0, m0, 4096
    s_add_u32 s67, s67, 262144
    s_cmp_lt_u32 s66, 2
    s_cselect_b32 s67, s67, 0x40000000
    buffer_load_dwordx4 v8, s[32:35], s67 offen nt lds
    s_barrier
    s_mov_b32 m0, s56
    s_mov_b32 s70, s21
    s_mov_b32 s71, s56
    s_lshl_b32 s67, s70, 12
    s_add_u32 s67, s67, s71
    buffer_load_dwordx4 v4, s[24:27], s67 offen nt lds
    s_add_u32 m0, m0, 4096
    s_add_u32 s70, s70, 11
    s_and_b32 s70, s70, 31
    s_add_u32 s71, s71, 131072
    s_lshl_b32 s67, s70, 12
    s_add_u32 s67, s67, s71
    buffer_load_dwordx4 v5, s[24:27], s67 offen nt lds
    s_add_u32 m0, m0, 4096
    s_add_u32 s70, s70, 11
    s_and_b32 s70, s70, 31
    s_add_u32 s71, s71, 131072
    s_lshl_b32 s67, s70, 12
    s_add_u32 s67, s67, s71
    buffer_load_dwordx4 v4, s[24:27], s67 offen nt lds
    s_add_u32 m0, m0, 4096
    s_add_u32 s70, s70, 11
    s_and_b32 s70, s70, 31
    s_add_u32 s71, s71, 131072
    s_lshl_b32 s67, s70, 12
    s_add_u32 s67, s67, s71
    buffer_load_dwordx4 v5, s[24:27], s67 offen nt lds
    s_add_u32 m0, m0, 4096
    s_add_u32 s70, s70, 11
    s_and_b32 s70, s70, 31
    s_add_u32 s71, s71, 131072
    s_lshl_b32 s67, s70, 12
    s_add_u32 s67, s67, s71
    s_add_u32 s28, s8, s68
    s_addc_u32 s29, s9, 0
    s_and_b32 s29, s29, 0xffff
    s_mov_b32 s30, 2097152
    s_mov_b32 s31, 0x20000
    s_mov_b32 s40, s12
    s_and_b32 s41, s13, 0xffff
    s_mov_b32 s42, 3670016
    s_mov_b32 s43, 0x20000
    v_lshrrev_b32 v1, 5, v0
    v_and_b32 v2, 31, v0
    v_lshlrev_b32 v3, 1, v1
    v_xor_b32 v3, v3, v2
    s_and_b32 s52, s66, 1
    s_lshl_b32 s52, s52, 2
    v_xor_b32 v3, s52, v3
    v_lshlrev_b32 v3, 4, v3
    v_lshl_add_u32 v6, v1, 9, v3
    v_xor_b32 v7, 128, v6
    v_lshrrev_b32 v1, 4, v0
    v_mul_u32_u24 v1, 896, v1
    v_and_b32 v2, 15, v0
    v_lshl_add_u32 v9, v2, 4, v1
    v_cmp_le_u32 vcc, 8, v2
    s_cmp_eq_u32 s76, 3
    s_cselect_b64 s[52:53], vcc, 0
    v_mov_b32 v1, 0x40000000
    v_cndmask_b32 v9, v9, v1, s[52:53]
    s_lshl_b32 s52, s66, 2
    s_add_u32 s52, s52, 149504
    v_mov_b32 v10, s52
    v_and_b32 v1, 3, v0
    v_lshlrev_b32 v1, 2, v1
    v_add_u32 v12, 149520, v1
    s_mov_b32 s44, s18
    s_and_b32 s45, s19, 0xffff
    s_mov_b32 s46, 8388608
    s_mov_b32 s47, 0x20000
    s_lshl_b32 s52, s20, 17
    s_lshl_b32 s53, s75, 14
    s_add_u32 s52, s52, s53
    s_lshl_b32 s53, s66, 12
    s_add_u32 s52, s52, s53
    s_lshl_b32 s53, s76, 10
    s_add_u32 s52, s52, s53
    s_add_u32 s72, s52, 262144
    v_lshlrev_b32 v13, 4, v0
    s_lshl_b32 s53, s2, 13
    s_lshl_b32 s54, s20, 10
    s_add_u32 s53, s53, s54
    s_add_u32 s73, s53, 1310720
    s_cmp_lt_u32 s2, 28
    s_cselect_b32 s73, s73, 0x40000000
    s_cmp_eq_u32 s66, 0
    s_cselect_b32 s73, s73, 0x40000000
    s_waitcnt vmcnt(4)
    v_mov_b32 v11, 4
    s_mov_b64 exec, 1
    ds_write_b32 v10, v11
    s_mov_b64 exec, -1
    buffer_load_dwordx4 v4, s[24:27], s67 offen nt lds
    s_add_u32 m0, m0, 4096
    s_add_u32 s70, s70, 11
    s_and_b32 s70, s70, 31
    s_add_u32 s71, s71, 131072
    s_lshl_b32 s67, s70, 12
    s_add_u32 s67, s67, s71
    buffer_load_dwordx4 v5, s[24:27], s67 offen nt lds
    s_add_u32 m0, m0, 4096
    s_add_u32 s70, s70, 11
    s_and_b32 s70, s70, 31
    s_add_u32 s71, s71, 131072
    s_lshl_b32 s67, s70, 12
    s_add_u32 s67, s67, s71
    buffer_load_dwordx4 v4, s[24:27], s67 offen nt lds
    s_add_u32 m0, m0, 4096
    s_add_u32 s70, s70, 11
    s_and_b32 s70, s70, 31
    s_add_u32 s71, s71, 131072
    s_lshl_b32 s67, s70, 12
    s_add_u32 s67, s67, s71
    buffer_load_dwordx4 v5, s[24:27], s67 offen nt lds
    s_add_u32 m0, m0, 4096
    s_add_u32 s70, s70, 11
    s_and_b32 s70, s70, 31
    s_add_u32 s71, s71, 131072
    s_lshl_b32 s67, s70, 12
    s_add_u32 s67, s67, s71
    s_waitcnt vmcnt(7)
    buffer_load_dwordx4 v4, s[24:27], s67 offen nt lds
    s_add_u32 m0, m0, 4096
    s_add_u32 s70, s70, 11
    s_and_b32 s70, s70, 31
    s_add_u32 s71, s71, 131072
    s_lshl_b32 s67, s70, 12
    s_add_u32 s67, s67, s71
    s_waitcnt vmcnt(7)
    buffer_load_dwordx4 v5, s[24:27], s67 offen nt lds
    s_add_u32 m0, m0, 4096
    s_add_u32 s70, s70, 11
    s_and_b32 s70, s70, 31
    s_add_u32 s71, s71, 131072
    s_lshl_b32 s67, s70, 12
    s_add_u32 s67, s67, s71
    s_waitcnt vmcnt(7)
    buffer_load_dwordx4 v4, s[24:27], s67 offen nt lds
    s_add_u32 m0, m0, 4096
    s_add_u32 s70, s70, 11
    s_and_b32 s70, s70, 31
    s_add_u32 s71, s71, 131072
    s_lshl_b32 s67, s70, 12
    s_add_u32 s67, s67, s71
    s_waitcnt vmcnt(7)
    v_mov_b32 v11, 8
    s_mov_b64 exec, 1
    ds_write_b32 v10, v11
    s_mov_b64 exec, -1
    buffer_load_dwordx4 v5, s[24:27], s67 offen nt lds
    s_add_u32 m0, m0, 4096
    s_add_u32 s70, s70, 11
    s_and_b32 s70, s70, 31
    s_add_u32 s71, s71, 131072
    s_lshl_b32 s67, s70, 12
    s_add_u32 s67, s67, s71
    s_waitcnt vmcnt(7)
    buffer_load_dwordx4 v4, s[24:27], s67 offen nt lds
    s_add_u32 m0, m0, 4096
    s_add_u32 s70, s70, 11
    s_and_b32 s70, s70, 31
    s_add_u32 s71, s71, 131072
    s_lshl_b32 s67, s70, 12
    s_add_u32 s67, s67, s71
    s_waitcnt vmcnt(7)
    buffer_load_dwordx4 v5, s[24:27], s67 offen nt lds
    s_add_u32 m0, m0, 4096
    s_add_u32 s70, s70, 11
    s_and_b32 s70, s70, 31
    s_add_u32 s71, s71, 131072
    s_lshl_b32 s67, s70, 12
    s_add_u32 s67, s67, s71
    s_waitcnt vmcnt(7)
    buffer_load_dwordx4 v4, s[24:27], s67 offen nt lds
    s_add_u32 m0, m0, 4096
    s_add_u32 s70, s70, 11
    s_and_b32 s70, s70, 31
    s_add_u32 s71, s71, 131072
    s_lshl_b32 s67, s70, 12
    s_add_u32 s67, s67, s71
    s_waitcnt vmcnt(7)
    v_mov_b32 v11, 12
    s_mov_b64 exec, 1
    ds_write_b32 v10, v11
    s_mov_b64 exec, -1
    buffer_load_dwordx4 v5, s[24:27], s67 offen nt lds
    s_add_u32 m0, m0, 4096
    s_add_u32 s70, s70, 11
    s_and_b32 s70, s70, 31
    s_add_u32 s71, s71, 131072
    s_lshl_b32 s67, s70, 12
    s_add_u32 s67, s67, s71
    s_add_u32 m0, s56, 65536
    s_mov_b32 s70, s21
    s_mov_b32 s71, s56
    s_lshl_b32 s67, s70, 12
    s_add_u32 s67, s67, s71
    s_waitcnt vmcnt(7)
    buffer_load_dwordx4 v6, s[28:31], s67 offen nt lds
    s_add_u32 m0, m0, 4096
    s_add_u32 s70, s70, 11
    s_and_b32 s70, s70, 31
    s_add_u32 s71, s71, 131072
    s_lshl_b32 s67, s70, 12
    s_add_u32 s67, s67, s71
    s_waitcnt vmcnt(7)
    buffer_load_dwordx4 v7, s[28:31], s67 offen nt lds
    s_add_u32 m0, m0, 4096
    s_add_u32 s70, s70, 11
    s_and_b32 s70, s70, 31
    s_add_u32 s71, s71, 131072
    s_lshl_b32 s67, s70, 12
    s_add_u32 s67, s67, s71
    s_waitcnt vmcnt(7)
    buffer_load_dwordx4 v6, s[28:31], s67 offen nt lds
    s_add_u32 m0, m0, 4096
    s_add_u32 s70, s70, 11
    s_and_b32 s70, s70, 31
    s_add_u32 s71, s71, 131072
    s_lshl_b32 s67, s70, 12
    s_add_u32 s67, s67, s71
    s_waitcnt vmcnt(7)
    v_mov_b32 v11, 16
    s_mov_b64 exec, 1
    ds_write_b32 v10, v11
    s_mov_b64 exec, -1
    buffer_load_dwordx4 v7, s[28:31], s67 offen nt lds
    s_add_u32 m0, m0, 4096
    s_add_u32 s70, s70, 11
    s_and_b32 s70, s70, 31
    s_add_u32 s71, s71, 131072
    s_lshl_b32 s67, s70, 12
    s_add_u32 s67, s67, s71
    s_waitcnt vmcnt(7)
    buffer_load_dwordx4 v6, s[28:31], s67 offen nt lds
    s_add_u32 m0, m0, 4096
    s_add_u32 s70, s70, 11
    s_and_b32 s70, s70, 31
    s_add_u32 s71, s71, 131072
    s_lshl_b32 s67, s70, 12
    s_add_u32 s67, s67, s71
    s_waitcnt vmcnt(7)
    buffer_load_dwordx4 v7, s[28:31], s67 offen nt lds
    s_add_u32 m0, m0, 4096
    s_add_u32 s70, s70, 11
    s_and_b32 s70, s70, 31
    s_add_u32 s71, s71, 131072
    s_lshl_b32 s67, s70, 12
    s_add_u32 s67, s67, s71
    s_waitcnt vmcnt(7)
    buffer_load_dwordx4 v6, s[28:31], s67 offen nt lds
    s_add_u32 m0, m0, 4096
    s_add_u32 s70, s70, 11
    s_and_b32 s70, s70, 31
    s_add_u32 s71, s71, 131072
    s_lshl_b32 s67, s70, 12
    s_add_u32 s67, s67, s71
    s_waitcnt vmcnt(7)
    v_mov_b32 v11, 20
    s_mov_b64 exec, 1
    ds_write_b32 v10, v11
    s_mov_b64 exec, -1
    buffer_load_dwordx4 v7, s[28:31], s67 offen nt lds
    s_add_u32 m0, m0, 4096
    s_add_u32 s70, s70, 11
    s_and_b32 s70, s70, 31
    s_add_u32 s71, s71, 131072
    s_lshl_b32 s67, s70, 12
    s_add_u32 s67, s67, s71
    s_waitcnt vmcnt(7)
    buffer_load_dwordx4 v6, s[28:31], s67 offen nt lds
    s_add_u32 m0, m0, 4096
    s_add_u32 s70, s70, 11
    s_and_b32 s70, s70, 31
    s_add_u32 s71, s71, 131072
    s_lshl_b32 s67, s70, 12
    s_add_u32 s67, s67, s71
    s_waitcnt vmcnt(7)
    buffer_load_dwordx4 v7, s[28:31], s67 offen nt lds
    s_add_u32 m0, m0, 4096
    s_add_u32 s70, s70, 11
    s_and_b32 s70, s70, 31
    s_add_u32 s71, s71, 131072
    s_lshl_b32 s67, s70, 12
    s_add_u32 s67, s67, s71
    s_waitcnt vmcnt(7)
    buffer_load_dwordx4 v6, s[28:31], s67 offen nt lds
    s_add_u32 m0, m0, 4096
    s_add_u32 s70, s70, 11
    s_and_b32 s70, s70, 31
    s_add_u32 s71, s71, 131072
    s_lshl_b32 s67, s70, 12
    s_add_u32 s67, s67, s71
    s_waitcnt vmcnt(7)
    v_mov_b32 v11, 24
    s_mov_b64 exec, 1
    ds_write_b32 v10, v11
    s_mov_b64 exec, -1
    buffer_load_dwordx4 v7, s[28:31], s67 offen nt lds
    s_add_u32 m0, m0, 4096
    s_add_u32 s70, s70, 11
    s_and_b32 s70, s70, 31
    s_add_u32 s71, s71, 131072
    s_lshl_b32 s67, s70, 12
    s_add_u32 s67, s67, s71
    s_waitcnt vmcnt(7)
    buffer_load_dwordx4 v6, s[28:31], s67 offen nt lds
    s_add_u32 m0, m0, 4096
    s_add_u32 s70, s70, 11
    s_and_b32 s70, s70, 31
    s_add_u32 s71, s71, 131072
    s_lshl_b32 s67, s70, 12
    s_add_u32 s67, s67, s71
    s_waitcnt vmcnt(7)
    buffer_load_dwordx4 v7, s[28:31], s67 offen nt lds
    s_add_u32 m0, m0, 4096
    s_add_u32 s70, s70, 11
    s_and_b32 s70, s70, 31
    s_add_u32 s71, s71, 131072
    s_lshl_b32 s67, s70, 12
    s_add_u32 s67, s67, s71
    s_waitcnt vmcnt(7)
    buffer_load_dwordx4 v6, s[28:31], s67 offen nt lds
    s_add_u32 m0, m0, 4096
    s_add_u32 s70, s70, 11
    s_and_b32 s70, s70, 31
    s_add_u32 s71, s71, 131072
    s_lshl_b32 s67, s70, 12
    s_add_u32 s67, s67, s71
    s_waitcnt vmcnt(7)
    v_mov_b32 v11, 28
    s_mov_b64 exec, 1
    ds_write_b32 v10, v11
    s_mov_b64 exec, -1
    buffer_load_dwordx4 v7, s[28:31], s67 offen nt lds
    s_add_u32 m0, m0, 4096
    s_add_u32 s70, s70, 11
    s_and_b32 s70, s70, 31
    s_add_u32 s71, s71, 131072
    s_lshl_b32 s67, s70, 12
    s_add_u32 s67, s67, s71
    s_lshl_b32 s52, s20, 9
    s_lshl_b32 s53, s75, 5
    s_add_u32 s52, s52, s53
    s_lshl_b32 s53, s66, 2
    s_add_u32 s52, s52, s53
    s_mul_i32 s52, s52, 896
    s_lshl_b32 s53, s76, 8
    s_add_u32 s67, s52, s53
    s_add_u32 m0, s56, 131072
L_lfq_14:
    ds_read_b32 v1, v12 offset:0
    s_waitcnt lgkmcnt(0)
    v_cmp_ne_u32 vcc, 0, v1
    s_cmp_eq_u64 vcc, -1
    s_cbranch_scc1 L_lfq_14_ok
    s_sleep 1
    s_branch L_lfq_14
L_lfq_14_ok:
    s_waitcnt vmcnt(7)
    buffer_load_dwordx4 v9, s[40:43], s67 offen nt lds
    s_add_u32 m0, m0, 4096
    s_add_u32 s67, s67, 14336
    s_waitcnt vmcnt(7)
    buffer_load_dwordx4 v9, s[40:43], s67 offen nt lds
    s_add_u32 m0, m0, 4096
    s_add_u32 s67, s67, 215040
    s_waitcnt vmcnt(7)
    buffer_load_dwordx4 v9, s[40:43], s67 offen nt lds
    s_add_u32 m0, m0, 4096
    s_add_u32 s67, s67, 14336
    s_waitcnt vmcnt(7)
    v_mov_b32 v11, 32
    s_mov_b64 exec, 1
    ds_write_b32 v10, v11
    s_mov_b64 exec, -1
    buffer_load_dwordx4 v9, s[40:43], s67 offen nt lds
    buffer_load_dwordx4 v[16:19], v13, s[44:47], s72 offen
    buffer_load_dwordx4 v[24:27], v13, s[44:47], s73 offen
    s_setprio 3
    s_mov_b64 exec, 1
    v_mov_b32 v11, 36
    s_waitcnt vmcnt(6)
    ds_write_b32 v10, v11
    s_barrier
    v_mov_b32 v14, 40
    s_waitcnt vmcnt(2)
    ds_write_b32 v10, v14
    s_mov_b64 exec, -1
    s_endpgm
L_end:
    s_endpgm
.section .rodata,"a"
.p2align 6
.amdhsa_kernel standalone__sliding_block_cached__decode_kernel
  .amdhsa_next_free_vgpr 256
  .amdhsa_next_free_sgpr 102
  .amdhsa_accum_offset 256
  .amdhsa_group_segment_fixed_size 0
  .amdhsa_kernarg_size 64
  .amdhsa_user_sgpr_count 2
  .amdhsa_user_sgpr_kernarg_segment_ptr 1
  .amdhsa_system_sgpr_workgroup_id_x 1
  .amdhsa_float_denorm_mode_32 3
.end_amdhsa_kernel
```
